```python
import torch

def _softmax(x, axis=-1):
    return torch.softmax(x, dim=axis)
def _gelu(x):
    return torch.nn.functional.gelu(x, approximate="tanh")
def _silu(x):
    return torch.nn.functional.silu(x)
def _sigmoid(x):
    return torch.sigmoid(x)
def _layernorm(x, axis=-1, eps=1e-5):
    m = x.mean(dim=axis, keepdim=True)
    v = x.var(dim=axis, keepdim=True, unbiased=False)
    return (x - m) / torch.sqrt(v + eps)
def _scatter_add(tgt, idx, src, axis=0):
    return tgt.clone().index_add_(axis, idx, src)
def _segment_sum(src, seg, n):
    out = torch.zeros((n,) + src.shape[1:], dtype=src.dtype)
    return out.index_add_(0, seg, src)
def _pad(x, pw):
    flat = tuple(v for pair in reversed(pw) for v in pair)
    return torch.nn.functional.pad(x, flat)

kernel_name = 'standalone__kv_cache_quant_int4_int2_kv_with_per_channel_or_per_token_scales__decode'

def setup_inputs():

    _w = (lambda a: (lambda t: t.to(torch.bfloat16) if t.is_floating_point() else t)(torch.as_tensor(a)))
    B = 4
    Sq = 1
    Skv = 8192
    Hq = 32
    Hkv = 8
    Dh = 128
    bits = 2
    G = 64
    if G <= 0 or G >= Skv:
        G = max(1, Skv // 2)
    Skv = (Skv // G) * G
    ngk = Skv // G
    qmax = (1 << bits) - 1
    return {
        "q": _w((lambda *s: torch.randn(*s, dtype=torch.bfloat16) * 3.2)(B, Hq, Sq, Dh)),
        "qk": _w(torch.randint(0, qmax + 1, (B, Hkv, Skv, Dh)).to(torch.int32)),
        "qv": _w(torch.randint(0, qmax + 1, (B, Hkv, Skv, Dh)).to(torch.int32)),
        "k_scales": _w(torch.abs((lambda *s: torch.randn(*s, dtype=torch.bfloat16) * 3.2)(B, Hkv, ngk, Dh)) * 0.05 + 0.02),
        "k_zeros": _w((lambda *s: torch.randn(*s, dtype=torch.bfloat16) * 3.2)(B, Hkv, ngk, Dh) + float(qmax) / 2.0),
        "v_scales": _w(torch.abs((lambda *s: torch.randn(*s, dtype=torch.bfloat16) * 0.05)(B, Hkv, Skv, 1)) * 0.05 + 0.02),
        "v_zeros": _w((lambda *s: torch.randn(*s, dtype=torch.bfloat16) * 0.05)(B, Hkv, Skv, 1) + float(qmax) / 2.0),
    }

def reference(q, qk, qv, k_scales, k_zeros, v_scales, v_zeros):
    B, Hq, Sq, Dh = q.shape
    Hkv, Skv = qk.shape[1], qk.shape[2]
    ngk = k_scales.shape[2]
    G = Skv // ngk
    ks = (lambda x, n, axis: torch.repeat_interleave(x, n, dim=axis))(k_scales, G, axis=2)
    kz = (lambda x, n, axis: torch.repeat_interleave(x, n, dim=axis))(k_zeros, G, axis=2)
    k = ((lambda x, dt: x.to(dt))(qk, q.dtype) - kz) * ks
    v = ((lambda x, dt: x.to(dt))(qv, q.dtype) - v_zeros) * v_scales
    rep = Hq // Hkv
    if rep > 1:
        k = (lambda x, n, axis: torch.repeat_interleave(x, n, dim=axis))(k, rep, axis=1)
        v = (lambda x, n, axis: torch.repeat_interleave(x, n, dim=axis))(v, rep, axis=1)
    scale = float(Dh) ** -0.5
    logits = torch.einsum("bhqd,bhkd->bhqk", q, k) * scale
    p = _softmax(logits, axis=-1)
    o = torch.einsum("bhqk,bhkd->bhqd", p, v)
    return o
```

```asm
; @launch grid=(256,1,1) block=(256,1,1) lds=52224
.amdgcn_target "amdgcn-amd-amdhsa--gfx950"
.text
.globl standalone__kv_cache_quant_int4_int2_kv_with_per_channel_or_per_token_scales__decode_kernel
.p2align 8
.type standalone__kv_cache_quant_int4_int2_kv_with_per_channel_or_per_token_scales__decode_kernel,@function
standalone__kv_cache_quant_int4_int2_kv_with_per_channel_or_per_token_scales__decode_kernel:
  s_cmp_ge_u32 s2, 256
  s_cbranch_scc1 L_end
  s_load_dwordx2 s[4:5], s[0:1], 8
  s_load_dwordx2 s[12:13], s[0:1], 24
  s_load_dwordx2 s[16:17], s[0:1], 32
  s_load_dwordx2 s[28:29], s[0:1], 0
  s_mov_b32 s6, 0x8000000
  s_mov_b32 s7, 0x20000
  s_mov_b32 s14, 0x100000
  s_mov_b32 s15, 0x20000
  s_mov_b32 s18, 0x100000
  s_mov_b32 s19, 0x20000
  s_mov_b32 s30, 0x8000
  s_mov_b32 s31, 0x20000
  v_lshrrev_b32 v182, 6, v0
  v_and_b32 v1, 63, v0
  v_lshlrev_b32 v2, 4, v1
  v_readfirstlane_b32 s3, v182
  v_and_b32 v182, 31, v1
  v_lshlrev_b32 v4, 3, v182
  v_lshrrev_b32 v183, 5, v1
  v_and_b32 v184, 7, v1
  v_lshl_add_u32 v184, v184, 1, v183
  v_lshlrev_b32 v5, 1, v184
  s_lshr_b32 s51, s2, 1
  s_xor_b32 s53, s51, s2
  s_and_b32 s53, s53, 1
  s_lshr_b32 s52, s2, 4
  s_xor_b32 s51, s51, s52
  s_and_b32 s51, s51, 3
  s_bfe_u32 s60, s2, 0x10003
  s_lshl_b32 s52, s52, 1
  s_or_b32 s52, s52, s53
  s_lshl_b32 s56, s52, 10
  s_lshl_b32 s45, s51, 8
  s_lshl_b32 s53, s60, 3
  s_add_u32 s45, s45, s53
  s_add_u32 s45, s45, s56
  s_lshl_b32 s53, s3, 1
  s_add_u32 s45, s45, s53
  s_mov_b32 s66, s45
  s_mov_b32 s71, 0
  s_and_b32 s53, s52, 2
  s_bcnt1_i32_b32 s53, s53
  s_and_b32 s53, s53, 1
  s_lshl_b32 s53, s53, 7
  s_or_b32 s71, s71, s53
  s_add_u32 s45, s45, s71
  s_lshl_b32 s51, s51, 1
  s_or_b32 s60, s60, s51
  s_lshl_b32 s46, s45, 12
  s_add_u32 s54, s46, 4096
  s_lshr_b32 s47, s45, 3
  s_lshl_b32 s47, s47, 8
  v_and_b32 v185, 3, v1
  v_lshlrev_b32 v185, 8, v185
  v_lshrrev_b32 v186, 4, v1
  v_lshl_add_u32 v185, v186, 4, v185
  s_waitcnt lgkmcnt(0)
  buffer_load_dwordx2 v[12:13], v4, s[16:19], s47 offen nt
  buffer_load_dwordx2 v[14:15], v4, s[12:15], s47 offen nt
  buffer_load_dwordx4 v[116:119], v2, s[4:7], s46 offen offset:0 nt
  buffer_load_dwordx4 v[120:123], v2, s[4:7], s46 offen offset:1024 nt
  buffer_load_dwordx4 v[124:127], v2, s[4:7], s46 offen offset:2048 nt
  buffer_load_dwordx4 v[128:131], v2, s[4:7], s46 offen offset:3072 nt
  buffer_load_dwordx4 v[132:135], v2, s[4:7], s54 offen offset:0 nt
  buffer_load_dwordx4 v[136:139], v2, s[4:7], s54 offen offset:1024 nt
  buffer_load_dwordx4 v[52:55], v185, s[28:31], s56 offen offset:0
  buffer_load_dwordx4 v[56:59], v185, s[28:31], s56 offen offset:64
  buffer_load_dwordx4 v[60:63], v185, s[28:31], s56 offen offset:128
  buffer_load_dwordx4 v[64:67], v185, s[28:31], s56 offen offset:192
  s_load_dwordx2 s[8:9], s[0:1], 16
  s_load_dwordx2 s[20:21], s[0:1], 40
  s_load_dwordx2 s[24:25], s[0:1], 48
  s_load_dwordx2 s[40:41], s[0:1], 56
  s_load_dwordx2 s[36:37], s[0:1], 64
  s_load_dwordx2 s[32:33], s[0:1], 72
  s_mov_b32 s10, 0x8000000
  s_mov_b32 s11, 0x20000
  s_mov_b32 s22, 0x80000
  s_mov_b32 s23, 0x20000
  s_mov_b32 s26, 0x80000
  s_mov_b32 s27, 0x20000
  s_mov_b32 s42, 0x8000
  s_mov_b32 s43, 0x20000
  s_mov_b32 s38, 0x100
  s_mov_b32 s39, 0x20000
  s_mov_b32 s34, 0x20000000
  s_mov_b32 s35, 0x20000
  s_mov_b32 s98, 0x8000000
  s_mov_b32 s99, 0x20000
  s_mov_b64 s[96:97], s[4:5]
  s_mov_b64 s[28:29], s[4:5]
  s_mov_b32 s30, 0x8000000
  v_mov_b32 v16, 0
  v_mov_b32 v17, 0
  s_mul_i32 s51, s3, 4608
  v_mul_u32_u24 v6, 2304, v183
  v_lshl_add_u32 v6, v182, 3, v6
  v_add_u32 v6, s51, v6
  v_and_b32 v187, 15, v1
  v_mul_u32_u24 v7, 288, v187
  v_lshl_add_u32 v7, v186, 4, v7
  v_add_u32 v7, s51, v7
  v_lshlrev_b32 v188, 3, v1
  s_mul_i32 s51, s3, 8192
  s_add_u32 s51, s51, 19456
  v_add_u32 v3, s51, v188
  s_mul_i32 s51, s3, 4608
  v_and_b32 v200, 7, v1
  v_lshl_add_u32 v200, v186, 3, v200
  v_lshl_add_u32 v200, v200, 4, s51
  v_add_u32 v201, s51, v188
  v_lshlrev_b32 v202, 4, v182
  v_lshl_add_u32 v202, v183, 10, v202
  v_and_b32 v203, 3, v1
  v_lshlrev_b32 v204, 8, v203
  v_lshlrev_b32 v203, 3, v203
  v_bfe_u32 v205, v1, 2, 1
  v_lshl_add_u32 v204, v205, 7, v204
  v_bfe_u32 v205, v1, 3, 2
  v_lshl_add_u32 v204, v205, 5, v204
  v_lshl_add_u32 v204, v183, 2, v204
  v_bfe_i32 v9, v1, 2, 1
  v_not_b32 v8, v9
  v_mov_b32 v10, 0xff800000
  v_mov_b32 v193, 0xff800000
  v_mov_b32 v11, 0
  v_mov_b32 v191, 0
  v_mov_b32 v192, 1
  v_mov_b32 v190, 0
  v_mov_b32 v100, 0
  v_mov_b32 v101, 0
  v_mov_b32 v102, 0
  v_mov_b32 v103, 0
  v_mov_b32 v104, 0
  v_mov_b32 v105, 0
  v_mov_b32 v106, 0
  v_mov_b32 v107, 0
  v_mov_b32 v108, 0
  v_mov_b32 v109, 0
  v_mov_b32 v110, 0
  v_mov_b32 v111, 0
  v_mov_b32 v112, 0
  v_mov_b32 v113, 0
  v_mov_b32 v114, 0
  v_mov_b32 v115, 0
  s_mov_b32 s50, 0x3fb8aa3b
  s_mov_b32 s49, 0
  s_mov_b32 s62, 0
  s_mov_b32 s58, 0
  s_mov_b32 s61, 0
  s_mov_b32 s67, 0
  s_mov_b32 s64, 0xffff0000
  s_mov_b32 s65, 0xffff0000
  s_lshl_b32 s44, s52, 3
  s_or_b32 s44, s44, s60
  s_lshl_b32 s57, s52, 8
  s_add_u32 s57, s57, 0x200000
  v_mov_b32 v197, 18432
  s_lshl_b32 s70, s52, 3
  s_add_u32 s70, s70, 4
  s_cmp_eq_u32 s60, 0
  s_cselect_b32 s59, 1, 0
  s_cmp_lg_u32 s3, 0
  s_waitcnt lgkmcnt(0)
  s_cbranch_scc1 L_w0done
  ds_write_b128 v2, v[100:103] offset:18432
  s_cmp_eq_u32 s59, 0
  s_cbranch_scc1 L_w0done
  s_atomic_swap s58, s[32:33], s57 glc
  s_mov_b32 s68, 4
  s_add_u32 s51, s57, 8
  s_atomic_add s68, s[32:33], s51 glc
  s_mov_b32 s61, 1
L_w0done:
L_kloop:
  s_waitcnt vmcnt(6)
  v_lshlrev_b32 v20, 16, v12
  v_and_b32 v21, 0xffff0000, v12
  v_lshlrev_b32 v22, 16, v13
  v_and_b32 v23, 0xffff0000, v13
  v_lshlrev_b32 v24, 16, v14
  v_and_b32 v25, 0xffff0000, v14
  v_lshlrev_b32 v26, 16, v15
  v_and_b32 v27, 0xffff0000, v15
  s_waitcnt vmcnt(5)
  buffer_load_dwordx4 v[140:143], v2, s[28:31], s54 offen offset:2048 nt
  v_cvt_f32_i32 v36, v116
  v_cvt_f32_i32 v37, v117
  v_cvt_f32_i32 v38, v118
  v_cvt_f32_i32 v39, v119
  v_pk_add_f32 v[36:37], v[36:37], v[20:21] neg_lo:[0,1] neg_hi:[0,1]
  v_pk_add_f32 v[38:39], v[38:39], v[22:23] neg_lo:[0,1] neg_hi:[0,1]
  v_cvt_pk_bf16_f32 v36, 0, v36
  v_cvt_pk_bf16_f32 v37, 0, v37
  v_cvt_pk_bf16_f32 v38, 0, v38
  v_cvt_pk_bf16_f32 v39, 0, v39
  v_pk_mul_f32 v[36:37], v[36:37], v[24:25]
  v_pk_mul_f32 v[38:39], v[38:39], v[26:27]
  v_cvt_pk_bf16_f32 v40, v36, v37
  v_cvt_pk_bf16_f32 v41, v38, v39
  ds_write_b64 v6, v[40:41] offset:0
  s_cmp_eq_u32 s49, 0
  s_cbranch_scc1 L_kfirst
  s_waitcnt lgkmcnt(1)
  v_mfma_f32_16x16x32_bf16 v[28:31], v[68:71], v[52:55], 0
  v_mfma_f32_16x16x32_bf16 v[28:31], v[72:75], v[56:59], v[28:31]
  v_mfma_f32_16x16x32_bf16 v[28:31], v[76:79], v[60:63], v[28:31]
  v_mfma_f32_16x16x32_bf16 v[28:31], v[80:83], v[64:67], v[28:31]
L_kfirst:
  s_waitcnt vmcnt(5)
  buffer_load_dwordx4 v[144:147], v2, s[28:31], s54 offen offset:3072 nt
  v_cvt_f32_i32 v44, v120
  v_cvt_f32_i32 v45, v121
  v_cvt_f32_i32 v46, v122
  v_cvt_f32_i32 v47, v123
  v_pk_add_f32 v[44:45], v[44:45], v[20:21] neg_lo:[0,1] neg_hi:[0,1]
  v_pk_add_f32 v[46:47], v[46:47], v[22:23] neg_lo:[0,1] neg_hi:[0,1]
  v_cvt_pk_bf16_f32 v44, 0, v44
  v_cvt_pk_bf16_f32 v45, 0, v45
  v_cvt_pk_bf16_f32 v46, 0, v46
  v_cvt_pk_bf16_f32 v47, 0, v47
  v_pk_mul_f32 v[44:45], v[44:45], v[24:25]
  v_pk_mul_f32 v[46:47], v[46:47], v[26:27]
  v_cvt_pk_bf16_f32 v48, v44, v45
  v_cvt_pk_bf16_f32 v49, v46, v47
  ds_write_b64 v6, v[48:49] offset:288
  s_cmp_eq_u32 s49, 14
  s_cbranch_scc1 L_kswitch
  s_or_b32 s62, s62, 783
  s_add_u32 s62, s62, 1
  s_and_b32 s62, s62, 240
  s_xor_b32 s45, s62, s71
  s_add_u32 s45, s45, s66
  s_lshl_b32 s46, s45, 12
  s_add_u32 s54, s46, 4096
  s_lshr_b32 s47, s45, 3
  s_lshl_b32 s47, s47, 8
  buffer_load_dwordx2 v[12:13], v4, s[16:19], s47 offen nt
  buffer_load_dwordx2 v[14:15], v4, s[12:15], s47 offen nt
L_kgo:
  s_waitcnt vmcnt(7)
  buffer_load_dwordx4 v[116:119], v2, s[96:99], s46 offen offset:0 nt
  v_cvt_f32_i32 v36, v124
  v_cvt_f32_i32 v37, v125
  v_cvt_f32_i32 v38, v126
  v_cvt_f32_i32 v39, v127
  v_pk_add_f32 v[36:37], v[36:37], v[20:21] neg_lo:[0,1] neg_hi:[0,1]
  v_pk_add_f32 v[38:39], v[38:39], v[22:23] neg_lo:[0,1] neg_hi:[0,1]
  v_cvt_pk_bf16_f32 v36, 0, v36
  v_cvt_pk_bf16_f32 v37, 0, v37
  v_cvt_pk_bf16_f32 v38, 0, v38
  v_cvt_pk_bf16_f32 v39, 0, v39
  v_pk_mul_f32 v[36:37], v[36:37], v[24:25]
  v_pk_mul_f32 v[38:39], v[38:39], v[26:27]
  v_cvt_pk_bf16_f32 v40, v36, v37
  v_cvt_pk_bf16_f32 v41, v38, v39
  ds_write_b64 v6, v[40:41] offset:576
  s_cmp_eq_u32 s49, 0
  s_cbranch_scc1 L_kfirst2
  v_cvt_pk_bf16_f32 v28, 0, v28
  v_cvt_pk_bf16_f32 v29, 0, v29
  v_cvt_pk_bf16_f32 v30, 0, v30
  v_cvt_pk_bf16_f32 v31, 0, v31
  v_mul_f32 v28, 0x3db504f3, v28
  v_mul_f32 v29, 0x3db504f3, v29
  v_mul_f32 v30, 0x3db504f3, v30
  v_mul_f32 v31, 0x3db504f3, v31
  v_max3_f32 v10, v10, v28, v29
  v_max3_f32 v10, v10, v30, v31
  v_cvt_pk_bf16_f32 v198, v28, v29
  v_cvt_pk_bf16_f32 v199, v30, v31
  ds_write_b64 v3, v[198:199]
  v_add_u32 v3, 512, v3
L_kfirst2:
  s_waitcnt vmcnt(7)
  buffer_load_dwordx4 v[120:123], v2, s[96:99], s46 offen offset:1024 nt
  v_cvt_f32_i32 v44, v128
  v_cvt_f32_i32 v45, v129
  v_cvt_f32_i32 v46, v130
  v_cvt_f32_i32 v47, v131
  v_pk_add_f32 v[44:45], v[44:45], v[20:21] neg_lo:[0,1] neg_hi:[0,1]
  v_pk_add_f32 v[46:47], v[46:47], v[22:23] neg_lo:[0,1] neg_hi:[0,1]
  v_cvt_pk_bf16_f32 v44, 0, v44
  v_cvt_pk_bf16_f32 v45, 0, v45
  v_cvt_pk_bf16_f32 v46, 0, v46
  v_cvt_pk_bf16_f32 v47, 0, v47
  v_pk_mul_f32 v[44:45], v[44:45], v[24:25]
  v_pk_mul_f32 v[46:47], v[46:47], v[26:27]
  v_cvt_pk_bf16_f32 v48, v44, v45
  v_cvt_pk_bf16_f32 v49, v46, v47
  ds_write_b64 v6, v[48:49] offset:864
  s_waitcnt vmcnt(7)
  buffer_load_dwordx4 v[124:127], v2, s[96:99], s46 offen offset:2048 nt
  v_cvt_f32_i32 v36, v132
  v_cvt_f32_i32 v37, v133
  v_cvt_f32_i32 v38, v134
  v_cvt_f32_i32 v39, v135
  v_pk_add_f32 v[36:37], v[36:37], v[20:21] neg_lo:[0,1] neg_hi:[0,1]
  v_pk_add_f32 v[38:39], v[38:39], v[22:23] neg_lo:[0,1] neg_hi:[0,1]
  v_cvt_pk_bf16_f32 v36, 0, v36
  v_cvt_pk_bf16_f32 v37, 0, v37
  v_cvt_pk_bf16_f32 v38, 0, v38
  v_cvt_pk_bf16_f32 v39, 0, v39
  v_pk_mul_f32 v[36:37], v[36:37], v[24:25]
  v_pk_mul_f32 v[38:39], v[38:39], v[26:27]
  v_cvt_pk_bf16_f32 v40, v36, v37
  v_cvt_pk_bf16_f32 v41, v38, v39
  ds_write_b64 v6, v[40:41] offset:1152
  s_waitcnt vmcnt(7)
  buffer_load_dwordx4 v[128:131], v2, s[96:99], s46 offen offset:3072 nt
  v_cvt_f32_i32 v44, v136
  v_cvt_f32_i32 v45, v137
  v_cvt_f32_i32 v46, v138
  v_cvt_f32_i32 v47, v139
  v_pk_add_f32 v[44:45], v[44:45], v[20:21] neg_lo:[0,1] neg_hi:[0,1]
  v_pk_add_f32 v[46:47], v[46:47], v[22:23] neg_lo:[0,1] neg_hi:[0,1]
  v_cvt_pk_bf16_f32 v44, 0, v44
  v_cvt_pk_bf16_f32 v45, 0, v45
  v_cvt_pk_bf16_f32 v46, 0, v46
  v_cvt_pk_bf16_f32 v47, 0, v47
  v_pk_mul_f32 v[44:45], v[44:45], v[24:25]
  v_pk_mul_f32 v[46:47], v[46:47], v[26:27]
  v_cvt_pk_bf16_f32 v48, v44, v45
  v_cvt_pk_bf16_f32 v49, v46, v47
  ds_write_b64 v6, v[48:49] offset:1440
  s_waitcnt vmcnt(7)
  buffer_load_dwordx4 v[132:135], v2, s[28:31], s54 offen offset:0 nt
  v_cvt_f32_i32 v36, v140
  v_cvt_f32_i32 v37, v141
  v_cvt_f32_i32 v38, v142
  v_cvt_f32_i32 v39, v143
  v_pk_add_f32 v[36:37], v[36:37], v[20:21] neg_lo:[0,1] neg_hi:[0,1]
  v_pk_add_f32 v[38:39], v[38:39], v[22:23] neg_lo:[0,1] neg_hi:[0,1]
  v_cvt_pk_bf16_f32 v36, 0, v36
  v_cvt_pk_bf16_f32 v37, 0, v37
  v_cvt_pk_bf16_f32 v38, 0, v38
  v_cvt_pk_bf16_f32 v39, 0, v39
  v_pk_mul_f32 v[36:37], v[36:37], v[24:25]
  v_pk_mul_f32 v[38:39], v[38:39], v[26:27]
  v_cvt_pk_bf16_f32 v40, v36, v37
  v_cvt_pk_bf16_f32 v41, v38, v39
  ds_write_b64 v6, v[40:41] offset:1728
  s_waitcnt vmcnt(7)
  buffer_load_dwordx4 v[136:139], v2, s[28:31], s54 offen offset:1024 nt
  v_cvt_f32_i32 v44, v144
  v_cvt_f32_i32 v45, v145
  v_cvt_f32_i32 v46, v146
  v_cvt_f32_i32 v47, v147
  v_pk_add_f32 v[44:45], v[44:45], v[20:21] neg_lo:[0,1] neg_hi:[0,1]
  v_pk_add_f32 v[46:47], v[46:47], v[22:23] neg_lo:[0,1] neg_hi:[0,1]
  v_cvt_pk_bf16_f32 v44, 0, v44
  v_cvt_pk_bf16_f32 v45, 0, v45
  v_cvt_pk_bf16_f32 v46, 0, v46
  v_cvt_pk_bf16_f32 v47, 0, v47
  v_pk_mul_f32 v[44:45], v[44:45], v[24:25]
  v_pk_mul_f32 v[46:47], v[46:47], v[26:27]
  v_cvt_pk_bf16_f32 v48, v44, v45
  v_cvt_pk_bf16_f32 v49, v46, v47
  ds_write_b64 v6, v[48:49] offset:2016
  s_add_u32 s49, s49, 1
  s_cmp_lt_u32 s49, 15
  ds_read_b128 v[68:71], v7 offset:0
  ds_read_b128 v[72:75], v7 offset:64
  ds_read_b128 v[76:79], v7 offset:128
  ds_read_b128 v[80:83], v7 offset:192
  s_cbranch_scc1 L_kloop
  s_waitcnt lgkmcnt(0)
  v_mfma_f32_16x16x32_bf16 v[28:31], v[68:71], v[52:55], 0
  v_mfma_f32_16x16x32_bf16 v[28:31], v[72:75], v[56:59], v[28:31]
  v_mfma_f32_16x16x32_bf16 v[28:31], v[76:79], v[60:63], v[28:31]
  v_mfma_f32_16x16x32_bf16 v[28:31], v[80:83], v[64:67], v[28:31]
  s_cmp_eq_u32 s61, 0
  s_cbranch_scc1 L_noinst
  s_add_u32 s68, s68, 4
  s_or_b32 s68, s68, 3
  s_mov_b32 s69, 0
  s_atomic_cmpswap s[68:69], s[36:37], s70 glc
L_noinst:
  s_nop 7
  v_cvt_pk_bf16_f32 v28, 0, v28
  v_cvt_pk_bf16_f32 v29, 0, v29
  v_cvt_pk_bf16_f32 v30, 0, v30
  v_cvt_pk_bf16_f32 v31, 0, v31
  v_mul_f32 v28, 0x3db504f3, v28
  v_mul_f32 v29, 0x3db504f3, v29
  v_mul_f32 v30, 0x3db504f3, v30
  v_mul_f32 v31, 0x3db504f3, v31
  v_max3_f32 v10, v10, v28, v29
  v_max3_f32 v10, v10, v30, v31
  v_cvt_pk_bf16_f32 v198, v28, v29
  v_cvt_pk_bf16_f32 v199, v30, v31
  ds_write_b64 v3, v[198:199]
  v_add_u32 v3, 512, v3
  v_mov_b32 v183, v10
  v_subrev_u32 v3, 7680, v3
  s_mov_b32 s49, 0
  v_permlane16_swap_b32 v10, v183
  v_max_f32 v10, v10, v183
  v_mov_b32 v183, v10
  ds_read_b64 v[198:199], v3
  v_add_u32 v3, 512, v3
  v_permlane32_swap_b32 v10, v183
  v_max_f32 v10, v10, v183
  v_cvt_pk_bf16_f32 v10, 0, v10
  v_mul_f32 v180, 0xbfb8aa3b, v10
L_vloop:
  s_waitcnt vmcnt(6)
  v_mov_b32 v18, v16
  v_mov_b32 v19, v17
  s_waitcnt lgkmcnt(0)
  v_lshlrev_b32 v28, 16, v198
  v_and_b32 v29, 0xffff0000, v198
  v_lshlrev_b32 v30, 16, v199
  v_and_b32 v31, 0xffff0000, v199
  v_fma_f32 v28, v28, s50, v180
  v_fma_f32 v29, v29, s50, v180
  v_fma_f32 v30, v30, s50, v180
  v_fma_f32 v31, v31, s50, v180
  v_exp_f32 v28, v28
  v_exp_f32 v29, v29
  v_exp_f32 v30, v30
  v_exp_f32 v31, v31
  ds_read_b64 v[198:199], v3
  v_add_u32 v3, 512, v3
  s_waitcnt vmcnt(5)
  buffer_load_dwordx4 v[140:143], v2, s[28:31], s54 offen offset:2048 nt
  v_cvt_f32_i32 v36, v116
  v_cvt_f32_i32 v37, v117
  v_cvt_f32_i32 v38, v118
  v_cvt_f32_i32 v39, v119
  v_mov_b32_dpp v40, v18 row_newbcast:0 row_mask:0xf bank_mask:0xf
  v_mov_b32_dpp v41, v19 row_newbcast:0 row_mask:0xf bank_mask:0xf
  v_pk_add_f32 v[36:37], v[36:37], v[40:41] op_sel_hi:[1,0] neg_lo:[0,1] neg_hi:[0,1]
  v_pk_add_f32 v[38:39], v[38:39], v[40:41] op_sel_hi:[1,0] neg_lo:[0,1] neg_hi:[0,1]
  v_cvt_pk_bf16_f32 v36, 0, v36
  v_cvt_pk_bf16_f32 v37, 0, v37
  v_cvt_pk_bf16_f32 v38, 0, v38
  v_cvt_pk_bf16_f32 v39, 0, v39
  v_pk_mul_f32 v[36:37], v[36:37], v[40:41] op_sel:[0,1] op_sel_hi:[1,1]
  v_pk_mul_f32 v[38:39], v[38:39], v[40:41] op_sel:[0,1] op_sel_hi:[1,1]
  s_waitcnt vmcnt(5)
  buffer_load_dwordx4 v[144:147], v2, s[28:31], s54 offen offset:3072 nt
  v_cvt_f32_i32 v44, v120
  v_cvt_f32_i32 v45, v121
  v_cvt_f32_i32 v46, v122
  v_cvt_f32_i32 v47, v123
  v_mov_b32_dpp v48, v18 row_newbcast:1 row_mask:0xf bank_mask:0xf
  v_mov_b32_dpp v49, v19 row_newbcast:1 row_mask:0xf bank_mask:0xf
  v_pk_add_f32 v[44:45], v[44:45], v[48:49] op_sel_hi:[1,0] neg_lo:[0,1] neg_hi:[0,1]
  v_pk_add_f32 v[46:47], v[46:47], v[48:49] op_sel_hi:[1,0] neg_lo:[0,1] neg_hi:[0,1]
  v_cvt_pk_bf16_f32 v44, 0, v44
  v_cvt_pk_bf16_f32 v45, 0, v45
  v_cvt_pk_bf16_f32 v46, 0, v46
  v_cvt_pk_bf16_f32 v47, 0, v47
  v_pk_mul_f32 v[44:45], v[44:45], v[48:49] op_sel:[0,1] op_sel_hi:[1,1]
  v_pk_mul_f32 v[46:47], v[46:47], v[48:49] op_sel:[0,1] op_sel_hi:[1,1]
  v_cvt_pk_bf16_f32 v84, v36, v44
  v_cvt_pk_bf16_f32 v88, v37, v45
  v_cvt_pk_bf16_f32 v92, v38, v46
  v_cvt_pk_bf16_f32 v96, v39, v47
  v_add_f32 v184, v28, v29
  v_add_f32 v185, v30, v31
  v_add_f32 v11, v11, v184
  v_add_f32 v11, v11, v185
  v_cvt_pk_bf16_f32 v184, v28, v29
  v_cvt_pk_bf16_f32 v185, v30, v31
  v_and_b32 v32, v184, v8
  v_and_b32 v34, v184, v9
  v_and_b32 v33, v185, v8
  v_and_b32 v35, v185, v9
  s_nop 1
  v_permlane16_swap_b32 v32, v34
  v_permlane16_swap_b32 v33, v35
  s_barrier
  s_cmp_lg_u32 s61, 0
  s_cbranch_scc1 L_vctl
  s_cmp_ge_u32 s49, 11
  s_cbranch_scc1 L_vctl
L_vctl_done:
  s_or_b32 s62, s62, 783
  s_add_u32 s62, s62, 1
  s_and_b32 s62, s62, 240
  s_xor_b32 s45, s62, s71
  s_add_u32 s45, s45, s66
  s_lshl_b32 s46, s45, 12
  s_add_u32 s54, s46, 4096
  s_lshl_b32 s48, s45, 4
L_vgo:
  buffer_load_short_d16_hi v16, v5, s[24:27], s48 offen nt
  buffer_load_short_d16_hi v17, v5, s[20:23], s48 offen nt
  s_waitcnt vmcnt(7)
  buffer_load_dwordx4 v[116:119], v2, s[96:99], s46 offen offset:0 nt
  v_cvt_f32_i32 v36, v124
  v_cvt_f32_i32 v37, v125
  v_cvt_f32_i32 v38, v126
  v_cvt_f32_i32 v39, v127
  v_mov_b32_dpp v40, v18 row_newbcast:2 row_mask:0xf bank_mask:0xf
  v_mov_b32_dpp v41, v19 row_newbcast:2 row_mask:0xf bank_mask:0xf
  v_pk_add_f32 v[36:37], v[36:37], v[40:41] op_sel_hi:[1,0] neg_lo:[0,1] neg_hi:[0,1]
  v_pk_add_f32 v[38:39], v[38:39], v[40:41] op_sel_hi:[1,0] neg_lo:[0,1] neg_hi:[0,1]
  v_cvt_pk_bf16_f32 v36, 0, v36
  v_cvt_pk_bf16_f32 v37, 0, v37
  v_cvt_pk_bf16_f32 v38, 0, v38
  v_cvt_pk_bf16_f32 v39, 0, v39
  v_pk_mul_f32 v[36:37], v[36:37], v[40:41] op_sel:[0,1] op_sel_hi:[1,1]
  v_pk_mul_f32 v[38:39], v[38:39], v[40:41] op_sel:[0,1] op_sel_hi:[1,1]
  s_waitcnt vmcnt(7)
  buffer_load_dwordx4 v[120:123], v2, s[96:99], s46 offen offset:1024 nt
  v_cvt_f32_i32 v44, v128
  v_cvt_f32_i32 v45, v129
  v_cvt_f32_i32 v46, v130
  v_cvt_f32_i32 v47, v131
  v_mov_b32_dpp v48, v18 row_newbcast:3 row_mask:0xf bank_mask:0xf
  v_mov_b32_dpp v49, v19 row_newbcast:3 row_mask:0xf bank_mask:0xf
  v_pk_add_f32 v[44:45], v[44:45], v[48:49] op_sel_hi:[1,0] neg_lo:[0,1] neg_hi:[0,1]
  v_pk_add_f32 v[46:47], v[46:47], v[48:49] op_sel_hi:[1,0] neg_lo:[0,1] neg_hi:[0,1]
  v_cvt_pk_bf16_f32 v44, 0, v44
  v_cvt_pk_bf16_f32 v45, 0, v45
  v_cvt_pk_bf16_f32 v46, 0, v46
  v_cvt_pk_bf16_f32 v47, 0, v47
  v_pk_mul_f32 v[44:45], v[44:45], v[48:49] op_sel:[0,1] op_sel_hi:[1,1]
  v_pk_mul_f32 v[46:47], v[46:47], v[48:49] op_sel:[0,1] op_sel_hi:[1,1]
  v_cvt_pk_bf16_f32 v85, v36, v44
  v_cvt_pk_bf16_f32 v89, v37, v45
  v_cvt_pk_bf16_f32 v93, v38, v46
  v_cvt_pk_bf16_f32 v97, v39, v47
  s_cmp_lt_u32 s49, 13
  s_cbranch_scc1 L_elV
  s_cmp_eq_u32 s45, 32768
  s_cbranch_scc1 L_elV
  s_mov_b64 exec, 1
  ds_add_rtn_u32 v190, v197, v192 offset:4
  s_mov_b64 exec, -1
L_elV:
  s_waitcnt vmcnt(7)
  buffer_load_dwordx4 v[124:127], v2, s[96:99], s46 offen offset:2048 nt
  v_cvt_f32_i32 v36, v132
  v_cvt_f32_i32 v37, v133
  v_cvt_f32_i32 v38, v134
  v_cvt_f32_i32 v39, v135
  v_mov_b32_dpp v40, v18 row_newbcast:4 row_mask:0xf bank_mask:0xf
  v_mov_b32_dpp v41, v19 row_newbcast:4 row_mask:0xf bank_mask:0xf
  v_pk_add_f32 v[36:37], v[36:37], v[40:41] op_sel_hi:[1,0] neg_lo:[0,1] neg_hi:[0,1]
  v_pk_add_f32 v[38:39], v[38:39], v[40:41] op_sel_hi:[1,0] neg_lo:[0,1] neg_hi:[0,1]
  v_cvt_pk_bf16_f32 v36, 0, v36
  v_cvt_pk_bf16_f32 v37, 0, v37
  v_cvt_pk_bf16_f32 v38, 0, v38
  v_cvt_pk_bf16_f32 v39, 0, v39
  v_pk_mul_f32 v[36:37], v[36:37], v[40:41] op_sel:[0,1] op_sel_hi:[1,1]
  v_pk_mul_f32 v[38:39], v[38:39], v[40:41] op_sel:[0,1] op_sel_hi:[1,1]
  s_waitcnt vmcnt(7)
  buffer_load_dwordx4 v[128:131], v2, s[96:99], s46 offen offset:3072 nt
  v_cvt_f32_i32 v44, v136
  v_cvt_f32_i32 v45, v137
  v_cvt_f32_i32 v46, v138
  v_cvt_f32_i32 v47, v139
  v_mov_b32_dpp v48, v18 row_newbcast:5 row_mask:0xf bank_mask:0xf
  v_mov_b32_dpp v49, v19 row_newbcast:5 row_mask:0xf bank_mask:0xf
  v_pk_add_f32 v[44:45], v[44:45], v[48:49] op_sel_hi:[1,0] neg_lo:[0,1] neg_hi:[0,1]
  v_pk_add_f32 v[46:47], v[46:47], v[48:49] op_sel_hi:[1,0] neg_lo:[0,1] neg_hi:[0,1]
  v_cvt_pk_bf16_f32 v44, 0, v44
  v_cvt_pk_bf16_f32 v45, 0, v45
  v_cvt_pk_bf16_f32 v46, 0, v46
  v_cvt_pk_bf16_f32 v47, 0, v47
  v_pk_mul_f32 v[44:45], v[44:45], v[48:49] op_sel:[0,1] op_sel_hi:[1,1]
  v_pk_mul_f32 v[46:47], v[46:47], v[48:49] op_sel:[0,1] op_sel_hi:[1,1]
  v_cvt_pk_bf16_f32 v86, v36, v44
  v_cvt_pk_bf16_f32 v90, v37, v45
  v_cvt_pk_bf16_f32 v94, v38, v46
  v_cvt_pk_bf16_f32 v98, v39, v47
  s_cmp_lt_u32 s49, 13
  s_cbranch_scc1 L_rqV
  s_cmp_eq_u32 s45, 32768
  s_cbranch_scc1 L_rqV
  s_waitcnt lgkmcnt(0)
  v_readfirstlane_b32 s51, v190
  s_mov_b32 s58, 0x7ffffffe
  s_nop 2
  s_cmp_eq_u32 s51, 0
  s_cselect_b32 s61, 1, 0
  s_and_b32 s51, s61, s59
  s_cbranch_scc0 L_rqV
  s_mov_b32 s58, 1
  s_atomic_add s58, s[32:33], s57 glc
L_rqV:
  s_waitcnt vmcnt(7)
  buffer_load_dwordx4 v[132:135], v2, s[28:31], s54 offen offset:0 nt
  v_cvt_f32_i32 v36, v140
  v_cvt_f32_i32 v37, v141
  v_cvt_f32_i32 v38, v142
  v_cvt_f32_i32 v39, v143
  v_mov_b32_dpp v40, v18 row_newbcast:6 row_mask:0xf bank_mask:0xf
  v_mov_b32_dpp v41, v19 row_newbcast:6 row_mask:0xf bank_mask:0xf
  v_pk_add_f32 v[36:37], v[36:37], v[40:41] op_sel_hi:[1,0] neg_lo:[0,1] neg_hi:[0,1]
  v_pk_add_f32 v[38:39], v[38:39], v[40:41] op_sel_hi:[1,0] neg_lo:[0,1] neg_hi:[0,1]
  v_cvt_pk_bf16_f32 v36, 0, v36
  v_cvt_pk_bf16_f32 v37, 0, v37
  v_cvt_pk_bf16_f32 v38, 0, v38
  v_cvt_pk_bf16_f32 v39, 0, v39
  v_pk_mul_f32 v[36:37], v[36:37], v[40:41] op_sel:[0,1] op_sel_hi:[1,1]
  v_pk_mul_f32 v[38:39], v[38:39], v[40:41] op_sel:[0,1] op_sel_hi:[1,1]
  s_waitcnt vmcnt(7)
  buffer_load_dwordx4 v[136:139], v2, s[28:31], s54 offen offset:1024 nt
  v_cvt_f32_i32 v44, v144
  v_cvt_f32_i32 v45, v145
  v_cvt_f32_i32 v46, v146
  v_cvt_f32_i32 v47, v147
  v_mov_b32_dpp v48, v18 row_newbcast:7 row_mask:0xf bank_mask:0xf
  v_mov_b32_dpp v49, v19 row_newbcast:7 row_mask:0xf bank_mask:0xf
  v_pk_add_f32 v[44:45], v[44:45], v[48:49] op_sel_hi:[1,0] neg_lo:[0,1] neg_hi:[0,1]
  v_pk_add_f32 v[46:47], v[46:47], v[48:49] op_sel_hi:[1,0] neg_lo:[0,1] neg_hi:[0,1]
  v_cvt_pk_bf16_f32 v44, 0, v44
  v_cvt_pk_bf16_f32 v45, 0, v45
  v_cvt_pk_bf16_f32 v46, 0, v46
  v_cvt_pk_bf16_f32 v47, 0, v47
  v_pk_mul_f32 v[44:45], v[44:45], v[48:49] op_sel:[0,1] op_sel_hi:[1,1]
  v_pk_mul_f32 v[46:47], v[46:47], v[48:49] op_sel:[0,1] op_sel_hi:[1,1]
  v_cvt_pk_bf16_f32 v87, v36, v44
  v_cvt_pk_bf16_f32 v91, v37, v45
  v_cvt_pk_bf16_f32 v95, v38, v46
  v_cvt_pk_bf16_f32 v99, v39, v47
  s_add_u32 s49, s49, 1
  s_cmp_lt_u32 s49, 15
  v_mfma_f32_16x16x32_bf16 v[100:103], v[84:87], v[32:35], v[100:103]
  v_mfma_f32_16x16x32_bf16 v[104:107], v[88:91], v[32:35], v[104:107]
  v_mfma_f32_16x16x32_bf16 v[108:111], v[92:95], v[32:35], v[108:111]
  v_mfma_f32_16x16x32_bf16 v[112:115], v[96:99], v[32:35], v[112:115]
  s_cbranch_scc1 L_vloop
  s_cmp_eq_u32 s45, 32768
  s_cbranch_scc1 L_epi
  buffer_load_dwordx4 v[140:143], v2, s[28:31], s54 offen offset:2048 nt
  buffer_load_dwordx4 v[144:147], v2, s[28:31], s54 offen offset:3072 nt
  s_waitcnt vmcnt(4)
L_hloop:
  s_cmp_eq_u32 s61, 0
  s_cbranch_scc1 L_tpH
  s_waitcnt lgkmcnt(0)
  s_add_u32 s51, s58, 1
  v_mov_b32 v190, s51
  ds_write_b32 v197, v190
  s_branch L_tgH
L_tpH:
  ds_read_b32 v190, v197
  s_waitcnt lgkmcnt(0)
  v_readfirstlane_b32 s51, v190
  s_nop 3
  s_cmp_eq_u32 s51, 0
  s_cbranch_scc1 L_tpH
  s_sub_u32 s58, s51, 1
L_tgH:
  v_add_u32 v197, 8, v197
  s_and_b32 s45, s58, 1
  s_lshl_b32 s45, s45, 3
  s_and_b32 s53, s58, 6
  s_lshl_b32 s53, s53, 7
  s_add_u32 s45, s45, s53
  s_and_b32 s53, s58, 8
  s_lshr_b32 s53, s53, 1
  s_add_u32 s45, s45, s53
  s_add_u32 s45, s45, s3
  s_add_u32 s45, s45, s56
  s_lshr_b32 s51, s58, 4
  s_mov_b32 s53, 240
  s_xor_b32 s53, s53, s71
  s_add_u32 s45, s45, s53
  s_cmp_lt_u32 s58, 16
  s_cselect_b32 s45, s45, 32768
  s_cbranch_scc0 L_hlast
  s_waitcnt vmcnt(10)
  v_lshlrev_b32 v20, 16, v12
  v_and_b32 v21, 0xffff0000, v12
  v_lshlrev_b32 v22, 16, v13
  v_and_b32 v23, 0xffff0000, v13
  v_lshlrev_b32 v24, 16, v14
  v_and_b32 v25, 0xffff0000, v14
  v_lshlrev_b32 v26, 16, v15
  v_and_b32 v27, 0xffff0000, v15
  s_lshl_b32 s46, s45, 12
  s_add_u32 s54, s46, 0
  s_lshr_b32 s47, s45, 3
  s_lshl_b32 s47, s47, 8
  s_lshl_b32 s48, s45, 4
  buffer_load_dwordx2 v[12:13], v4, s[16:19], s47 offen nt
  buffer_load_dwordx2 v[14:15], v4, s[12:15], s47 offen nt
  s_waitcnt vmcnt(11)
  v_cvt_f32_i32 v36, v116
  v_cvt_f32_i32 v37, v117
  v_cvt_f32_i32 v38, v118
  v_cvt_f32_i32 v39, v119
  buffer_load_dwordx4 v[116:119], v2, s[96:99], s46 offen offset:0 nt
  v_pk_add_f32 v[36:37], v[36:37], v[20:21] neg_lo:[0,1] neg_hi:[0,1]
  v_pk_add_f32 v[38:39], v[38:39], v[22:23] neg_lo:[0,1] neg_hi:[0,1]
  v_cvt_pk_bf16_f32 v36, 0, v36
  v_cvt_pk_bf16_f32 v37, 0, v37
  v_cvt_pk_bf16_f32 v38, 0, v38
  v_cvt_pk_bf16_f32 v39, 0, v39
  v_pk_mul_f32 v[36:37], v[36:37], v[24:25]
  v_pk_mul_f32 v[38:39], v[38:39], v[26:27]
  v_cvt_pk_bf16_f32 v40, v36, v37
  v_cvt_pk_bf16_f32 v41, v38, v39
  ds_write_b64 v6, v[40:41] offset:0
  s_waitcnt vmcnt(11)
  v_cvt_f32_i32 v44, v120
  v_cvt_f32_i32 v45, v121
  v_cvt_f32_i32 v46, v122
  v_cvt_f32_i32 v47, v123
  buffer_load_dwordx4 v[120:123], v2, s[96:99], s46 offen offset:1024 nt
  v_pk_add_f32 v[44:45], v[44:45], v[20:21] neg_lo:[0,1] neg_hi:[0,1]
  v_pk_add_f32 v[46:47], v[46:47], v[22:23] neg_lo:[0,1] neg_hi:[0,1]
  v_cvt_pk_bf16_f32 v44, 0, v44
  v_cvt_pk_bf16_f32 v45, 0, v45
  v_cvt_pk_bf16_f32 v46, 0, v46
  v_cvt_pk_bf16_f32 v47, 0, v47
  v_pk_mul_f32 v[44:45], v[44:45], v[24:25]
  v_pk_mul_f32 v[46:47], v[46:47], v[26:27]
  v_cvt_pk_bf16_f32 v48, v44, v45
  v_cvt_pk_bf16_f32 v49, v46, v47
  ds_write_b64 v6, v[48:49] offset:288
  s_waitcnt vmcnt(11)
  v_cvt_f32_i32 v36, v124
  v_cvt_f32_i32 v37, v125
  v_cvt_f32_i32 v38, v126
  v_cvt_f32_i32 v39, v127
  buffer_load_dwordx4 v[124:127], v2, s[96:99], s46 offen offset:2048 nt
  v_pk_add_f32 v[36:37], v[36:37], v[20:21] neg_lo:[0,1] neg_hi:[0,1]
  v_pk_add_f32 v[38:39], v[38:39], v[22:23] neg_lo:[0,1] neg_hi:[0,1]
  v_cvt_pk_bf16_f32 v36, 0, v36
  v_cvt_pk_bf16_f32 v37, 0, v37
  v_cvt_pk_bf16_f32 v38, 0, v38
  v_cvt_pk_bf16_f32 v39, 0, v39
  v_pk_mul_f32 v[36:37], v[36:37], v[24:25]
  v_pk_mul_f32 v[38:39], v[38:39], v[26:27]
  v_cvt_pk_bf16_f32 v40, v36, v37
  v_cvt_pk_bf16_f32 v41, v38, v39
  ds_write_b64 v6, v[40:41] offset:576
  s_waitcnt vmcnt(11)
  v_cvt_f32_i32 v44, v128
  v_cvt_f32_i32 v45, v129
  v_cvt_f32_i32 v46, v130
  v_cvt_f32_i32 v47, v131
  buffer_load_dwordx4 v[128:131], v2, s[96:99], s46 offen offset:3072 nt
  v_pk_add_f32 v[44:45], v[44:45], v[20:21] neg_lo:[0,1] neg_hi:[0,1]
  v_pk_add_f32 v[46:47], v[46:47], v[22:23] neg_lo:[0,1] neg_hi:[0,1]
  v_cvt_pk_bf16_f32 v44, 0, v44
  v_cvt_pk_bf16_f32 v45, 0, v45
  v_cvt_pk_bf16_f32 v46, 0, v46
  v_cvt_pk_bf16_f32 v47, 0, v47
  v_pk_mul_f32 v[44:45], v[44:45], v[24:25]
  v_pk_mul_f32 v[46:47], v[46:47], v[26:27]
  v_cvt_pk_bf16_f32 v48, v44, v45
  v_cvt_pk_bf16_f32 v49, v46, v47
  ds_write_b64 v6, v[48:49] offset:864
  ds_read_b128 v[68:71], v7 offset:0
  ds_read_b128 v[72:75], v7 offset:64
  ds_read_b128 v[76:79], v7 offset:128
  ds_read_b128 v[80:83], v7 offset:192
  s_mov_b64 exec, 1
  ds_add_rtn_u32 v190, v197, v192 offset:4
  s_mov_b64 exec, -1
  s_waitcnt vmcnt(10)
  v_mov_b32 v18, v16
  v_mov_b32 v19, v17
  buffer_load_short_d16_hi v16, v5, s[24:27], s48 offen nt
  buffer_load_short_d16_hi v17, v5, s[20:23], s48 offen nt
  s_waitcnt vmcnt(11)
  v_cvt_f32_i32 v36, v132
  v_cvt_f32_i32 v37, v133
  v_cvt_f32_i32 v38, v134
  v_cvt_f32_i32 v39, v135
  buffer_load_dwordx4 v[132:135], v2, s[28:31], s54 offen offset:0 nt
  v_mov_b32_dpp v40, v18 row_newbcast:0 row_mask:0xf bank_mask:0xf
  v_mov_b32_dpp v41, v19 row_newbcast:0 row_mask:0xf bank_mask:0xf
  v_pk_add_f32 v[36:37], v[36:37], v[40:41] op_sel_hi:[1,0] neg_lo:[0,1] neg_hi:[0,1]
  v_pk_add_f32 v[38:39], v[38:39], v[40:41] op_sel_hi:[1,0] neg_lo:[0,1] neg_hi:[0,1]
  v_cvt_pk_bf16_f32 v36, 0, v36
  v_cvt_pk_bf16_f32 v37, 0, v37
  v_cvt_pk_bf16_f32 v38, 0, v38
  v_cvt_pk_bf16_f32 v39, 0, v39
  v_pk_mul_f32 v[36:37], v[36:37], v[40:41] op_sel:[0,1] op_sel_hi:[1,1]
  v_pk_mul_f32 v[38:39], v[38:39], v[40:41] op_sel:[0,1] op_sel_hi:[1,1]
  s_waitcnt vmcnt(11)
  v_cvt_f32_i32 v44, v136
  v_cvt_f32_i32 v45, v137
  v_cvt_f32_i32 v46, v138
  v_cvt_f32_i32 v47, v139
  buffer_load_dwordx4 v[136:139], v2, s[28:31], s54 offen offset:1024 nt
  v_mov_b32_dpp v48, v18 row_newbcast:1 row_mask:0xf bank_mask:0xf
  v_mov_b32_dpp v49, v19 row_newbcast:1 row_mask:0xf bank_mask:0xf
  v_pk_add_f32 v[44:45], v[44:45], v[48:49] op_sel_hi:[1,0] neg_lo:[0,1] neg_hi:[0,1]
  v_pk_add_f32 v[46:47], v[46:47], v[48:49] op_sel_hi:[1,0] neg_lo:[0,1] neg_hi:[0,1]
  v_cvt_pk_bf16_f32 v44, 0, v44
  v_cvt_pk_bf16_f32 v45, 0, v45
  v_cvt_pk_bf16_f32 v46, 0, v46
  v_cvt_pk_bf16_f32 v47, 0, v47
  v_pk_mul_f32 v[44:45], v[44:45], v[48:49] op_sel:[0,1] op_sel_hi:[1,1]
  v_pk_mul_f32 v[46:47], v[46:47], v[48:49] op_sel:[0,1] op_sel_hi:[1,1]
  v_cvt_pk_bf16_f32 v84, v36, v44
  v_cvt_pk_bf16_f32 v88, v37, v45
  v_cvt_pk_bf16_f32 v92, v38, v46
  v_cvt_pk_bf16_f32 v96, v39, v47
  s_waitcnt lgkmcnt(0)
  v_mfma_f32_16x16x32_bf16 v[28:31], v[68:71], v[52:55], 0
  v_mfma_f32_16x16x32_bf16 v[28:31], v[72:75], v[56:59], v[28:31]
  v_mfma_f32_16x16x32_bf16 v[28:31], v[76:79], v[60:63], v[28:31]
  v_mfma_f32_16x16x32_bf16 v[28:31], v[80:83], v[64:67], v[28:31]
  v_readfirstlane_b32 s51, v190
  s_mov_b32 s58, 0x7ffffffe
  s_nop 2
  s_cmp_eq_u32 s51, 0
  s_cselect_b32 s61, 1, 0
  s_and_b32 s51, s61, s59
  s_cbranch_scc0 L_rqH
  s_mov_b32 s58, 1
  s_atomic_add s58, s[32:33], s57 glc
L_rqH:
  s_nop 7
  v_cvt_pk_bf16_f32 v28, 0, v28
  v_cvt_pk_bf16_f32 v29, 0, v29
  v_cvt_pk_bf16_f32 v30, 0, v30
  v_cvt_pk_bf16_f32 v31, 0, v31
  v_mul_f32 v28, 0x3db504f3, v28
  v_mul_f32 v29, 0x3db504f3, v29
  v_mul_f32 v30, 0x3db504f3, v30
  v_mul_f32 v31, 0x3db504f3, v31
  v_cvt_pk_bf16_f32 v28, 0, v28
  v_cvt_pk_bf16_f32 v29, 0, v29
  v_cvt_pk_bf16_f32 v30, 0, v30
  v_cvt_pk_bf16_f32 v31, 0, v31
  v_cndmask_b32 v28, v28, v193, s[64:65]
  v_cndmask_b32 v29, v29, v193, s[64:65]
  v_cndmask_b32 v30, v30, v193, s[64:65]
  v_cndmask_b32 v31, v31, v193, s[64:65]
  v_max3_f32 v182, v28, v29, v30
  v_max3_f32 v182, v182, v31, v10
  v_mov_b32 v183, v182
  s_nop 1
  v_permlane16_swap_b32 v182, v183
  v_max_f32 v182, v182, v183
  v_mov_b32 v183, v182
  s_nop 1
  v_permlane32_swap_b32 v182, v183
  v_max_f32 v10, v182, v183
  v_mul_f32 v183, 0xbfb8aa3b, v10
  v_sub_f32 v182, v183, v180
  v_exp_f32 v182, v182
  v_mov_b32 v180, v183
  v_fma_f32 v28, v28, s50, v183
  v_fma_f32 v29, v29, s50, v183
  v_fma_f32 v30, v30, s50, v183
  v_fma_f32 v31, v31, s50, v183
  v_exp_f32 v28, v28
  v_exp_f32 v29, v29
  v_exp_f32 v30, v30
  v_exp_f32 v31, v31
  v_mul_f32 v11, v11, v182
  v_pk_mul_f32 v[100:101], v[100:101], v[182:183] op_sel_hi:[1,0]
  v_pk_mul_f32 v[102:103], v[102:103], v[182:183] op_sel_hi:[1,0]
  v_pk_mul_f32 v[104:105], v[104:105], v[182:183] op_sel_hi:[1,0]
  v_pk_mul_f32 v[106:107], v[106:107], v[182:183] op_sel_hi:[1,0]
  v_pk_mul_f32 v[108:109], v[108:109], v[182:183] op_sel_hi:[1,0]
  v_pk_mul_f32 v[110:111], v[110:111], v[182:183] op_sel_hi:[1,0]
  v_pk_mul_f32 v[112:113], v[112:113], v[182:183] op_sel_hi:[1,0]
  v_pk_mul_f32 v[114:115], v[114:115], v[182:183] op_sel_hi:[1,0]
  v_add_f32 v184, v28, v29
  v_add_f32 v185, v30, v31
  v_add_f32 v11, v11, v184
  v_add_f32 v11, v11, v185
  v_cvt_pk_bf16_f32 v184, v28, v29
  v_cvt_pk_bf16_f32 v185, v30, v31
  v_and_b32 v32, v184, v8
  v_and_b32 v34, v184, v9
  v_and_b32 v33, v185, v8
  v_and_b32 v35, v185, v9
  s_nop 1
  v_permlane16_swap_b32 v32, v34
  v_permlane16_swap_b32 v33, v35
  s_waitcnt vmcnt(11)
  v_cvt_f32_i32 v36, v140
  v_cvt_f32_i32 v37, v141
  v_cvt_f32_i32 v38, v142
  v_cvt_f32_i32 v39, v143
  buffer_load_dwordx4 v[140:143], v2, s[28:31], s54 offen offset:2048 nt
  v_mov_b32_dpp v40, v18 row_newbcast:2 row_mask:0xf bank_mask:0xf
  v_mov_b32_dpp v41, v19 row_newbcast:2 row_mask:0xf bank_mask:0xf
  v_pk_add_f32 v[36:37], v[36:37], v[40:41] op_sel_hi:[1,0] neg_lo:[0,1] neg_hi:[0,1]
  v_pk_add_f32 v[38:39], v[38:39], v[40:41] op_sel_hi:[1,0] neg_lo:[0,1] neg_hi:[0,1]
  v_cvt_pk_bf16_f32 v36, 0, v36
  v_cvt_pk_bf16_f32 v37, 0, v37
  v_cvt_pk_bf16_f32 v38, 0, v38
  v_cvt_pk_bf16_f32 v39, 0, v39
  v_pk_mul_f32 v[36:37], v[36:37], v[40:41] op_sel:[0,1] op_sel_hi:[1,1]
  v_pk_mul_f32 v[38:39], v[38:39], v[40:41] op_sel:[0,1] op_sel_hi:[1,1]
  s_waitcnt vmcnt(11)
  v_cvt_f32_i32 v44, v144
  v_cvt_f32_i32 v45, v145
  v_cvt_f32_i32 v46, v146
  v_cvt_f32_i32 v47, v147
  buffer_load_dwordx4 v[144:147], v2, s[28:31], s54 offen offset:3072 nt
  v_mov_b32_dpp v48, v18 row_newbcast:3 row_mask:0xf bank_mask:0xf
  v_mov_b32_dpp v49, v19 row_newbcast:3 row_mask:0xf bank_mask:0xf
  v_pk_add_f32 v[44:45], v[44:45], v[48:49] op_sel_hi:[1,0] neg_lo:[0,1] neg_hi:[0,1]
  v_pk_add_f32 v[46:47], v[46:47], v[48:49] op_sel_hi:[1,0] neg_lo:[0,1] neg_hi:[0,1]
  v_cvt_pk_bf16_f32 v44, 0, v44
  v_cvt_pk_bf16_f32 v45, 0, v45
  v_cvt_pk_bf16_f32 v46, 0, v46
  v_cvt_pk_bf16_f32 v47, 0, v47
  v_pk_mul_f32 v[44:45], v[44:45], v[48:49] op_sel:[0,1] op_sel_hi:[1,1]
  v_pk_mul_f32 v[46:47], v[46:47], v[48:49] op_sel:[0,1] op_sel_hi:[1,1]
  v_cvt_pk_bf16_f32 v85, v36, v44
  v_cvt_pk_bf16_f32 v89, v37, v45
  v_cvt_pk_bf16_f32 v93, v38, v46
  v_cvt_pk_bf16_f32 v97, v39, v47
  s_add_u32 s49, s49, 1
  s_cmp_lg_u32 s45, 32768
  v_mfma_f32_16x16x16_bf16 v[100:103], v[84:85], v[32:33], v[100:103]
  v_mfma_f32_16x16x16_bf16 v[104:107], v[88:89], v[32:33], v[104:107]
  v_mfma_f32_16x16x16_bf16 v[108:111], v[92:93], v[32:33], v[108:111]
  v_mfma_f32_16x16x16_bf16 v[112:115], v[96:97], v[32:33], v[112:115]
  s_branch L_hloop
L_hlast:
  s_waitcnt vmcnt(10)
  v_lshlrev_b32 v20, 16, v12
  v_and_b32 v21, 0xffff0000, v12
  v_lshlrev_b32 v22, 16, v13
  v_and_b32 v23, 0xffff0000, v13
  v_lshlrev_b32 v24, 16, v14
  v_and_b32 v25, 0xffff0000, v14
  v_lshlrev_b32 v26, 16, v15
  v_and_b32 v27, 0xffff0000, v15
  s_waitcnt vmcnt(9)
  v_cvt_f32_i32 v36, v116
  v_cvt_f32_i32 v37, v117
  v_cvt_f32_i32 v38, v118
  v_cvt_f32_i32 v39, v119
  v_pk_add_f32 v[36:37], v[36:37], v[20:21] neg_lo:[0,1] neg_hi:[0,1]
  v_pk_add_f32 v[38:39], v[38:39], v[22:23] neg_lo:[0,1] neg_hi:[0,1]
  v_cvt_pk_bf16_f32 v36, 0, v36
  v_cvt_pk_bf16_f32 v37, 0, v37
  v_cvt_pk_bf16_f32 v38, 0, v38
  v_cvt_pk_bf16_f32 v39, 0, v39
  v_pk_mul_f32 v[36:37], v[36:37], v[24:25]
  v_pk_mul_f32 v[38:39], v[38:39], v[26:27]
  v_cvt_pk_bf16_f32 v40, v36, v37
  v_cvt_pk_bf16_f32 v41, v38, v39
  ds_write_b64 v6, v[40:41] offset:0
  s_waitcnt vmcnt(8)
  v_cvt_f32_i32 v44, v120
  v_cvt_f32_i32 v45, v121
  v_cvt_f32_i32 v46, v122
  v_cvt_f32_i32 v47, v123
  v_pk_add_f32 v[44:45], v[44:45], v[20:21] neg_lo:[0,1] neg_hi:[0,1]
  v_pk_add_f32 v[46:47], v[46:47], v[22:23] neg_lo:[0,1] neg_hi:[0,1]
  v_cvt_pk_bf16_f32 v44, 0, v44
  v_cvt_pk_bf16_f32 v45, 0, v45
  v_cvt_pk_bf16_f32 v46, 0, v46
  v_cvt_pk_bf16_f32 v47, 0, v47
  v_pk_mul_f32 v[44:45], v[44:45], v[24:25]
  v_pk_mul_f32 v[46:47], v[46:47], v[26:27]
  v_cvt_pk_bf16_f32 v48, v44, v45
  v_cvt_pk_bf16_f32 v49, v46, v47
  ds_write_b64 v6, v[48:49] offset:288
  s_waitcnt vmcnt(7)
  v_cvt_f32_i32 v36, v124
  v_cvt_f32_i32 v37, v125
  v_cvt_f32_i32 v38, v126
  v_cvt_f32_i32 v39, v127
  v_pk_add_f32 v[36:37], v[36:37], v[20:21] neg_lo:[0,1] neg_hi:[0,1]
  v_pk_add_f32 v[38:39], v[38:39], v[22:23] neg_lo:[0,1] neg_hi:[0,1]
  v_cvt_pk_bf16_f32 v36, 0, v36
  v_cvt_pk_bf16_f32 v37, 0, v37
  v_cvt_pk_bf16_f32 v38, 0, v38
  v_cvt_pk_bf16_f32 v39, 0, v39
  v_pk_mul_f32 v[36:37], v[36:37], v[24:25]
  v_pk_mul_f32 v[38:39], v[38:39], v[26:27]
  v_cvt_pk_bf16_f32 v40, v36, v37
  v_cvt_pk_bf16_f32 v41, v38, v39
  ds_write_b64 v6, v[40:41] offset:576
  s_waitcnt vmcnt(6)
  v_cvt_f32_i32 v44, v128
  v_cvt_f32_i32 v45, v129
  v_cvt_f32_i32 v46, v130
  v_cvt_f32_i32 v47, v131
  v_pk_add_f32 v[44:45], v[44:45], v[20:21] neg_lo:[0,1] neg_hi:[0,1]
  v_pk_add_f32 v[46:47], v[46:47], v[22:23] neg_lo:[0,1] neg_hi:[0,1]
  v_cvt_pk_bf16_f32 v44, 0, v44
  v_cvt_pk_bf16_f32 v45, 0, v45
  v_cvt_pk_bf16_f32 v46, 0, v46
  v_cvt_pk_bf16_f32 v47, 0, v47
  v_pk_mul_f32 v[44:45], v[44:45], v[24:25]
  v_pk_mul_f32 v[46:47], v[46:47], v[26:27]
  v_cvt_pk_bf16_f32 v48, v44, v45
  v_cvt_pk_bf16_f32 v49, v46, v47
  ds_write_b64 v6, v[48:49] offset:864
  ds_read_b128 v[68:71], v7 offset:0
  ds_read_b128 v[72:75], v7 offset:64
  ds_read_b128 v[76:79], v7 offset:128
  ds_read_b128 v[80:83], v7 offset:192
  s_waitcnt vmcnt(4)
  v_mov_b32 v18, v16
  v_mov_b32 v19, v17
  s_waitcnt vmcnt(3)
  v_cvt_f32_i32 v36, v132
  v_cvt_f32_i32 v37, v133
  v_cvt_f32_i32 v38, v134
  v_cvt_f32_i32 v39, v135
  v_mov_b32_dpp v40, v18 row_newbcast:0 row_mask:0xf bank_mask:0xf
  v_mov_b32_dpp v41, v19 row_newbcast:0 row_mask:0xf bank_mask:0xf
  v_pk_add_f32 v[36:37], v[36:37], v[40:41] op_sel_hi:[1,0] neg_lo:[0,1] neg_hi:[0,1]
  v_pk_add_f32 v[38:39], v[38:39], v[40:41] op_sel_hi:[1,0] neg_lo:[0,1] neg_hi:[0,1]
  v_cvt_pk_bf16_f32 v36, 0, v36
  v_cvt_pk_bf16_f32 v37, 0, v37
  v_cvt_pk_bf16_f32 v38, 0, v38
  v_cvt_pk_bf16_f32 v39, 0, v39
  v_pk_mul_f32 v[36:37], v[36:37], v[40:41] op_sel:[0,1] op_sel_hi:[1,1]
  v_pk_mul_f32 v[38:39], v[38:39], v[40:41] op_sel:[0,1] op_sel_hi:[1,1]
  s_waitcnt vmcnt(2)
  v_cvt_f32_i32 v44, v136
  v_cvt_f32_i32 v45, v137
  v_cvt_f32_i32 v46, v138
  v_cvt_f32_i32 v47, v139
  v_mov_b32_dpp v48, v18 row_newbcast:1 row_mask:0xf bank_mask:0xf
  v_mov_b32_dpp v49, v19 row_newbcast:1 row_mask:0xf bank_mask:0xf
  v_pk_add_f32 v[44:45], v[44:45], v[48:49] op_sel_hi:[1,0] neg_lo:[0,1] neg_hi:[0,1]
  v_pk_add_f32 v[46:47], v[46:47], v[48:49] op_sel_hi:[1,0] neg_lo:[0,1] neg_hi:[0,1]
  v_cvt_pk_bf16_f32 v44, 0, v44
  v_cvt_pk_bf16_f32 v45, 0, v45
  v_cvt_pk_bf16_f32 v46, 0, v46
  v_cvt_pk_bf16_f32 v47, 0, v47
  v_pk_mul_f32 v[44:45], v[44:45], v[48:49] op_sel:[0,1] op_sel_hi:[1,1]
  v_pk_mul_f32 v[46:47], v[46:47], v[48:49] op_sel:[0,1] op_sel_hi:[1,1]
  v_cvt_pk_bf16_f32 v84, v36, v44
  v_cvt_pk_bf16_f32 v88, v37, v45
  v_cvt_pk_bf16_f32 v92, v38, v46
  v_cvt_pk_bf16_f32 v96, v39, v47
  s_waitcnt lgkmcnt(0)
  v_mfma_f32_16x16x32_bf16 v[28:31], v[68:71], v[52:55], 0
  v_mfma_f32_16x16x32_bf16 v[28:31], v[72:75], v[56:59], v[28:31]
  v_mfma_f32_16x16x32_bf16 v[28:31], v[76:79], v[60:63], v[28:31]
  v_mfma_f32_16x16x32_bf16 v[28:31], v[80:83], v[64:67], v[28:31]
  s_waitcnt vmcnt(1)
  v_cvt_f32_i32 v36, v140
  v_cvt_f32_i32 v37, v141
  v_cvt_f32_i32 v38, v142
  v_cvt_f32_i32 v39, v143
  v_mov_b32_dpp v40, v18 row_newbcast:2 row_mask:0xf bank_mask:0xf
  v_mov_b32_dpp v41, v19 row_newbcast:2 row_mask:0xf bank_mask:0xf
  v_pk_add_f32 v[36:37], v[36:37], v[40:41] op_sel_hi:[1,0] neg_lo:[0,1] neg_hi:[0,1]
  v_pk_add_f32 v[38:39], v[38:39], v[40:41] op_sel_hi:[1,0] neg_lo:[0,1] neg_hi:[0,1]
  v_cvt_pk_bf16_f32 v36, 0, v36
  v_cvt_pk_bf16_f32 v37, 0, v37
  v_cvt_pk_bf16_f32 v38, 0, v38
  v_cvt_pk_bf16_f32 v39, 0, v39
  v_pk_mul_f32 v[36:37], v[36:37], v[40:41] op_sel:[0,1] op_sel_hi:[1,1]
  v_pk_mul_f32 v[38:39], v[38:39], v[40:41] op_sel:[0,1] op_sel_hi:[1,1]
  s_waitcnt vmcnt(0)
  v_cvt_f32_i32 v44, v144
  v_cvt_f32_i32 v45, v145
  v_cvt_f32_i32 v46, v146
  v_cvt_f32_i32 v47, v147
  v_mov_b32_dpp v48, v18 row_newbcast:3 row_mask:0xf bank_mask:0xf
  v_mov_b32_dpp v49, v19 row_newbcast:3 row_mask:0xf bank_mask:0xf
  v_pk_add_f32 v[44:45], v[44:45], v[48:49] op_sel_hi:[1,0] neg_lo:[0,1] neg_hi:[0,1]
  v_pk_add_f32 v[46:47], v[46:47], v[48:49] op_sel_hi:[1,0] neg_lo:[0,1] neg_hi:[0,1]
  v_cvt_pk_bf16_f32 v44, 0, v44
  v_cvt_pk_bf16_f32 v45, 0, v45
  v_cvt_pk_bf16_f32 v46, 0, v46
  v_cvt_pk_bf16_f32 v47, 0, v47
  v_pk_mul_f32 v[44:45], v[44:45], v[48:49] op_sel:[0,1] op_sel_hi:[1,1]
  v_pk_mul_f32 v[46:47], v[46:47], v[48:49] op_sel:[0,1] op_sel_hi:[1,1]
  v_cvt_pk_bf16_f32 v85, v36, v44
  v_cvt_pk_bf16_f32 v89, v37, v45
  v_cvt_pk_bf16_f32 v93, v38, v46
  v_cvt_pk_bf16_f32 v97, v39, v47
  v_cvt_pk_bf16_f32 v28, 0, v28
  v_cvt_pk_bf16_f32 v29, 0, v29
  v_cvt_pk_bf16_f32 v30, 0, v30
  v_cvt_pk_bf16_f32 v31, 0, v31
  v_mul_f32 v28, 0x3db504f3, v28
  v_mul_f32 v29, 0x3db504f3, v29
  v_mul_f32 v30, 0x3db504f3, v30
  v_mul_f32 v31, 0x3db504f3, v31
  v_cvt_pk_bf16_f32 v28, 0, v28
  v_cvt_pk_bf16_f32 v29, 0, v29
  v_cvt_pk_bf16_f32 v30, 0, v30
  v_cvt_pk_bf16_f32 v31, 0, v31
  v_cndmask_b32 v28, v28, v193, s[64:65]
  v_cndmask_b32 v29, v29, v193, s[64:65]
  v_cndmask_b32 v30, v30, v193, s[64:65]
  v_cndmask_b32 v31, v31, v193, s[64:65]
  v_max3_f32 v182, v28, v29, v30
  v_max3_f32 v182, v182, v31, v10
  v_mov_b32 v183, v182
  s_nop 1
  v_permlane16_swap_b32 v182, v183
  v_max_f32 v182, v182, v183
  v_mov_b32 v183, v182
  s_nop 1
  v_permlane32_swap_b32 v182, v183
  v_max_f32 v10, v182, v183
  v_mul_f32 v183, 0xbfb8aa3b, v10
  v_sub_f32 v182, v183, v180
  v_exp_f32 v182, v182
  v_mov_b32 v180, v183
  v_fma_f32 v28, v28, s50, v183
  v_fma_f32 v29, v29, s50, v183
  v_fma_f32 v30, v30, s50, v183
  v_fma_f32 v31, v31, s50, v183
  v_exp_f32 v28, v28
  v_exp_f32 v29, v29
  v_exp_f32 v30, v30
  v_exp_f32 v31, v31
  v_mul_f32 v11, v11, v182
  v_pk_mul_f32 v[100:101], v[100:101], v[182:183] op_sel_hi:[1,0]
  v_pk_mul_f32 v[102:103], v[102:103], v[182:183] op_sel_hi:[1,0]
  v_pk_mul_f32 v[104:105], v[104:105], v[182:183] op_sel_hi:[1,0]
  v_pk_mul_f32 v[106:107], v[106:107], v[182:183] op_sel_hi:[1,0]
  v_pk_mul_f32 v[108:109], v[108:109], v[182:183] op_sel_hi:[1,0]
  v_pk_mul_f32 v[110:111], v[110:111], v[182:183] op_sel_hi:[1,0]
  v_pk_mul_f32 v[112:113], v[112:113], v[182:183] op_sel_hi:[1,0]
  v_pk_mul_f32 v[114:115], v[114:115], v[182:183] op_sel_hi:[1,0]
  v_add_f32 v184, v28, v29
  v_add_f32 v185, v30, v31
  v_add_f32 v11, v11, v184
  v_add_f32 v11, v11, v185
  v_cvt_pk_bf16_f32 v184, v28, v29
  v_cvt_pk_bf16_f32 v185, v30, v31
  v_and_b32 v32, v184, v8
  v_and_b32 v34, v184, v9
  v_and_b32 v33, v185, v8
  v_and_b32 v35, v185, v9
  s_nop 1
  v_permlane16_swap_b32 v32, v34
  v_permlane16_swap_b32 v33, v35
  s_add_u32 s49, s49, 1
  s_cmp_lg_u32 s45, 32768
  v_mfma_f32_16x16x16_bf16 v[100:103], v[84:85], v[32:33], v[100:103]
  v_mfma_f32_16x16x16_bf16 v[104:107], v[88:89], v[32:33], v[104:107]
  v_mfma_f32_16x16x16_bf16 v[108:111], v[92:93], v[32:33], v[108:111]
  v_mfma_f32_16x16x16_bf16 v[112:115], v[96:97], v[32:33], v[112:115]
L_epi:
  v_mov_b32 v183, v11
  s_mov_b32 s64, 0x00ff00ff
  s_mov_b32 s65, 0x00ff00ff
  v_permlane16_swap_b32 v11, v183
  v_add_f32 v11, v11, v183
  v_mov_b32 v183, v11
  s_nop 1
  v_permlane32_swap_b32 v11, v183
  v_add_f32 v181, v11, v183
  s_mov_b64 exec, 15
  ds_write_b64 v201, v[180:181] offset:2048
  s_mov_b64 exec, s[64:65]
  ds_write_b128 v200, v[100:103] offset:0
  ds_write_b128 v200, v[104:107] offset:512
  ds_write_b128 v200, v[108:111] offset:1024
  ds_write_b128 v200, v[112:115] offset:1536
  s_mov_b64 exec, -1
  s_cmp_eq_u32 s67, 0
  s_cbranch_scc1 L_gettag
L_havetag:
  s_lshl_b32 s53, s52, 3
  s_cmp_gt_u32 s3, 1
  s_waitcnt vmcnt(0) lgkmcnt(0)
  s_barrier
  s_cbranch_scc1 L_end
  s_cmp_eq_u32 s3, 0
  s_cbranch_scc1 L_noatom
  s_mov_b64 exec, 1
  buffer_atomic_add v192, v191, s[36:39], s53 offen sc0
  s_mov_b64 exec, -1
L_noatom:
  ds_read_b64 v[44:45], v203 offset:2048
  ds_read_b64 v[46:47], v203 offset:6656
  ds_read_b64 v[48:49], v203 offset:11264
  ds_read_b64 v[50:51], v203 offset:15872
  ds_read_b128 v[116:119], v202 offset:0
  ds_read_b128 v[120:123], v202 offset:512
  ds_read_b128 v[124:127], v202 offset:4608
  ds_read_b128 v[128:131], v202 offset:5120
  ds_read_b128 v[132:135], v202 offset:9216
  ds_read_b128 v[136:139], v202 offset:9728
  ds_read_b128 v[140:143], v202 offset:13824
  ds_read_b128 v[144:147], v202 offset:14336
  v_mov_b32 v87, s67
  v_mov_b32 v91, s67
  v_mov_b32 v95, s67
  s_waitcnt lgkmcnt(8)
  v_min_f32 v52, v44, v46
  v_min3_f32 v52, v52, v48, v50
  v_sub_f32 v36, v52, v44
  v_sub_f32 v37, v52, v46
  v_sub_f32 v38, v52, v48
  v_sub_f32 v39, v52, v50
  v_exp_f32 v36, v36
  v_exp_f32 v37, v37
  v_exp_f32 v38, v38
  v_exp_f32 v39, v39
  s_nop 0
  v_mul_f32 v53, v36, v45
  v_fmac_f32 v53, v37, v47
  v_fmac_f32 v53, v38, v49
  v_fmac_f32 v53, v39, v51
  v_rcp_f32 v54, v53
  v_log_f32 v55, v53
  s_nop 0
  v_mul_f32 v36, v36, v54
  v_mul_f32 v37, v37, v54
  v_mul_f32 v38, v38, v54
  v_mul_f32 v39, v39, v54
  v_sub_f32 v94, v55, v52
  s_waitcnt lgkmcnt(0)
  v_mul_f32 v84, v36, v116
  v_mul_f32 v85, v36, v117
  v_mul_f32 v86, v36, v118
  v_mul_f32 v88, v36, v119
  v_mul_f32 v89, v36, v120
  v_mul_f32 v90, v36, v121
  v_mul_f32 v92, v36, v122
  v_mul_f32 v93, v36, v123
  v_fmac_f32 v84, v37, v124
  v_fmac_f32 v85, v37, v125
  v_fmac_f32 v86, v37, v126
  v_fmac_f32 v88, v37, v127
  v_fmac_f32 v89, v37, v128
  v_fmac_f32 v90, v37, v129
  v_fmac_f32 v92, v37, v130
  v_fmac_f32 v93, v37, v131
  v_fmac_f32 v84, v38, v132
  v_fmac_f32 v85, v38, v133
  v_fmac_f32 v86, v38, v134
  v_fmac_f32 v88, v38, v135
  v_fmac_f32 v89, v38, v136
  v_fmac_f32 v90, v38, v137
  v_fmac_f32 v92, v38, v138
  v_fmac_f32 v93, v38, v139
  v_fmac_f32 v84, v39, v140
  v_fmac_f32 v85, v39, v141
  v_fmac_f32 v86, v39, v142
  v_fmac_f32 v88, v39, v143
  v_fmac_f32 v89, v39, v144
  v_fmac_f32 v90, v39, v145
  v_fmac_f32 v92, v39, v146
  v_fmac_f32 v93, v39, v147
  s_lshl_b32 s51, s44, 12
  s_cmp_lg_u32 s3, 0
  s_cbranch_scc1 L_fin
  buffer_store_dwordx4 v[84:87], v2, s[32:35], s51 offen offset:0 sc1
  buffer_store_dwordx4 v[88:91], v2, s[32:35], s51 offen offset:1024 sc1
  buffer_store_dwordx4 v[92:95], v2, s[32:35], s51 offen offset:2048 sc1
  s_endpgm
L_fin:
  s_lshl_b32 s51, s52, 15
  s_add_u32 s53, s60, 1
  s_and_b32 s53, s53, 7
  s_lshl_b32 s53, s53, 12
  s_add_u32 s12, s53, s51
  s_add_u32 s53, s60, 2
  s_and_b32 s53, s53, 7
  s_lshl_b32 s53, s53, 12
  s_add_u32 s13, s53, s51
  s_add_u32 s53, s60, 3
  s_and_b32 s53, s53, 7
  s_lshl_b32 s53, s53, 12
  s_add_u32 s14, s53, s51
  s_add_u32 s53, s60, 4
  s_and_b32 s53, s53, 7
  s_lshl_b32 s53, s53, 12
  s_add_u32 s15, s53, s51
  s_add_u32 s53, s60, 5
  s_and_b32 s53, s53, 7
  s_lshl_b32 s53, s53, 12
  s_add_u32 s16, s53, s51
  s_add_u32 s53, s60, 6
  s_and_b32 s53, s53, 7
  s_lshl_b32 s53, s53, 12
  s_add_u32 s17, s53, s51
  s_add_u32 s53, s60, 7
  s_and_b32 s53, s53, 7
  s_lshl_b32 s53, s53, 12
  s_add_u32 s18, s53, s51
  s_mov_b32 s63, 0x40000
  s_waitcnt vmcnt(0)
  v_readfirstlane_b32 s61, v192
  s_nop 3
  s_cmp_lg_u32 s61, 7
  s_cbranch_scc1 L_end
L_poll:
  s_sub_u32 s63, s63, 1
  s_cbranch_scc1 L_end
  buffer_load_dwordx4 v[104:107], v2, s[32:35], s12 offen offset:2048 sc1
  buffer_load_dwordx4 v[116:119], v2, s[32:35], s13 offen offset:2048 sc1
  buffer_load_dwordx4 v[128:131], v2, s[32:35], s14 offen offset:2048 sc1
  buffer_load_dwordx4 v[140:143], v2, s[32:35], s15 offen offset:2048 sc1
  buffer_load_dwordx4 v[152:155], v2, s[32:35], s16 offen offset:2048 sc1
  buffer_load_dwordx4 v[164:167], v2, s[32:35], s17 offen offset:2048 sc1
  buffer_load_dwordx4 v[176:179], v2, s[32:35], s18 offen offset:2048 sc1
  buffer_load_dwordx4 v[96:99], v2, s[32:35], s12 offen sc1
  buffer_load_dwordx4 v[100:103], v2, s[32:35], s12 offen offset:1024 sc1
  buffer_load_dwordx4 v[108:111], v2, s[32:35], s13 offen sc1
  buffer_load_dwordx4 v[112:115], v2, s[32:35], s13 offen offset:1024 sc1
  buffer_load_dwordx4 v[120:123], v2, s[32:35], s14 offen sc1
  buffer_load_dwordx4 v[124:127], v2, s[32:35], s14 offen offset:1024 sc1
  buffer_load_dwordx4 v[132:135], v2, s[32:35], s15 offen sc1
  buffer_load_dwordx4 v[136:139], v2, s[32:35], s15 offen offset:1024 sc1
  buffer_load_dwordx4 v[144:147], v2, s[32:35], s16 offen sc1
  buffer_load_dwordx4 v[148:151], v2, s[32:35], s16 offen offset:1024 sc1
  buffer_load_dwordx4 v[156:159], v2, s[32:35], s17 offen sc1
  buffer_load_dwordx4 v[160:163], v2, s[32:35], s17 offen offset:1024 sc1
  buffer_load_dwordx4 v[168:171], v2, s[32:35], s18 offen sc1
  buffer_load_dwordx4 v[172:175], v2, s[32:35], s18 offen offset:1024 sc1
  s_waitcnt vmcnt(14)
  v_max_f32 v52, v94, v106
  v_max3_f32 v52, v52, v118, v130
  v_max3_f32 v52, v52, v142, v154
  v_max3_f32 v52, v52, v166, v178
  v_sub_f32 v36, v94, v52
  v_sub_f32 v37, v106, v52
  v_sub_f32 v38, v118, v52
  v_sub_f32 v39, v130, v52
  v_sub_f32 v40, v142, v52
  v_sub_f32 v41, v154, v52
  v_sub_f32 v42, v166, v52
  v_sub_f32 v43, v178, v52
  v_exp_f32 v36, v36
  v_exp_f32 v37, v37
  v_exp_f32 v38, v38
  v_exp_f32 v39, v39
  v_exp_f32 v40, v40
  v_exp_f32 v41, v41
  v_exp_f32 v42, v42
  v_exp_f32 v43, v43
  v_min_u32 v184, v95, v107
  v_max_u32 v185, v95, v107
  v_min3_u32 v184, v184, v119, v131
  v_max3_u32 v185, v185, v119, v131
  v_min3_u32 v184, v184, v143, v155
  v_max3_u32 v185, v185, v143, v155
  v_min3_u32 v184, v184, v167, v179
  v_max3_u32 v185, v185, v167, v179
  v_add_f32 v53, v36, v37
  v_add_f32 v53, v53, v38
  v_add_f32 v53, v53, v39
  v_add_f32 v53, v53, v40
  v_add_f32 v53, v53, v41
  v_add_f32 v53, v53, v42
  v_add_f32 v53, v53, v43
  v_rcp_f32 v53, v53
  v_mul_f32 v20, v36, v84
  v_mul_f32 v21, v36, v85
  v_mul_f32 v22, v36, v86
  v_mul_f32 v23, v36, v88
  v_mul_f32 v24, v36, v89
  v_mul_f32 v25, v36, v90
  v_mul_f32 v26, v36, v92
  v_mul_f32 v27, v36, v93
  v_fmac_f32 v26, v37, v104
  v_fmac_f32 v27, v37, v105
  v_fmac_f32 v26, v38, v116
  v_fmac_f32 v27, v38, v117
  v_fmac_f32 v26, v39, v128
  v_fmac_f32 v27, v39, v129
  v_fmac_f32 v26, v40, v140
  v_fmac_f32 v27, v40, v141
  v_fmac_f32 v26, v41, v152
  v_fmac_f32 v27, v41, v153
  v_fmac_f32 v26, v42, v164
  v_fmac_f32 v27, v42, v165
  v_fmac_f32 v26, v43, v176
  v_fmac_f32 v27, v43, v177
  s_waitcnt vmcnt(12)
  v_fmac_f32 v20, v37, v96
  v_fmac_f32 v21, v37, v97
  v_fmac_f32 v22, v37, v98
  v_fmac_f32 v23, v37, v100
  v_fmac_f32 v24, v37, v101
  v_fmac_f32 v25, v37, v102
  v_min3_u32 v184, v184, v99, v103
  v_max3_u32 v185, v185, v99, v103
  s_waitcnt vmcnt(10)
  v_fmac_f32 v20, v38, v108
  v_fmac_f32 v21, v38, v109
  v_fmac_f32 v22, v38, v110
  v_fmac_f32 v23, v38, v112
  v_fmac_f32 v24, v38, v113
  v_fmac_f32 v25, v38, v114
  v_min3_u32 v184, v184, v111, v115
  v_max3_u32 v185, v185, v111, v115
  s_waitcnt vmcnt(8)
  v_fmac_f32 v20, v39, v120
  v_fmac_f32 v21, v39, v121
  v_fmac_f32 v22, v39, v122
  v_fmac_f32 v23, v39, v124
  v_fmac_f32 v24, v39, v125
  v_fmac_f32 v25, v39, v126
  v_min3_u32 v184, v184, v123, v127
  v_max3_u32 v185, v185, v123, v127
  s_waitcnt vmcnt(6)
  v_fmac_f32 v20, v40, v132
  v_fmac_f32 v21, v40, v133
  v_fmac_f32 v22, v40, v134
  v_fmac_f32 v23, v40, v136
  v_fmac_f32 v24, v40, v137
  v_fmac_f32 v25, v40, v138
  v_min3_u32 v184, v184, v135, v139
  v_max3_u32 v185, v185, v135, v139
  s_waitcnt vmcnt(4)
  v_fmac_f32 v20, v41, v144
  v_fmac_f32 v21, v41, v145
  v_fmac_f32 v22, v41, v146
  v_fmac_f32 v23, v41, v148
  v_fmac_f32 v24, v41, v149
  v_fmac_f32 v25, v41, v150
  v_min3_u32 v184, v184, v147, v151
  v_max3_u32 v185, v185, v147, v151
  s_waitcnt vmcnt(2)
  v_fmac_f32 v20, v42, v156
  v_fmac_f32 v21, v42, v157
  v_fmac_f32 v22, v42, v158
  v_fmac_f32 v23, v42, v160
  v_fmac_f32 v24, v42, v161
  v_fmac_f32 v25, v42, v162
  v_min3_u32 v184, v184, v159, v163
  v_max3_u32 v185, v185, v159, v163
  s_waitcnt vmcnt(0)
  v_fmac_f32 v20, v43, v168
  v_fmac_f32 v21, v43, v169
  v_fmac_f32 v22, v43, v170
  v_fmac_f32 v23, v43, v172
  v_fmac_f32 v24, v43, v173
  v_fmac_f32 v25, v43, v174
  v_min3_u32 v184, v184, v171, v175
  v_max3_u32 v185, v185, v171, v175
  v_cmp_ne_u32 vcc, v184, v185
  v_mul_f32 v20, v20, v53
  v_mul_f32 v21, v21, v53
  v_mul_f32 v22, v22, v53
  v_mul_f32 v23, v23, v53
  v_mul_f32 v24, v24, v53
  v_mul_f32 v25, v25, v53
  v_mul_f32 v26, v26, v53
  v_mul_f32 v27, v27, v53
  s_cbranch_vccnz L_poll
  v_cvt_pk_bf16_f32 v28, v20, v24
  v_cvt_pk_bf16_f32 v29, v21, v25
  v_cvt_pk_bf16_f32 v30, v22, v26
  v_cvt_pk_bf16_f32 v31, v23, v27
  buffer_store_dword v28, v204, s[40:43], s56 offen offset:0
  buffer_store_dword v29, v204, s[40:43], s56 offen offset:8
  buffer_store_dword v30, v204, s[40:43], s56 offen offset:16
  buffer_store_dword v31, v204, s[40:43], s56 offen offset:24
L_end:
  s_endpgm
L_gettag:
  s_mov_b32 s68, 4
  s_add_u32 s51, s57, 8
  s_atomic_add s68, s[32:33], s51 glc
  s_waitcnt lgkmcnt(0)
  s_add_u32 s68, s68, 4
  s_andn2_b32 s68, s68, 3
  s_or_b32 s67, s68, 2
  s_mov_b32 s68, s67
  s_mov_b32 s69, 0
  s_atomic_cmpswap s[68:69], s[36:37], s70 glc
  s_waitcnt lgkmcnt(0)
  s_andn2_b32 s68, s68, 1
  s_cmp_eq_u32 s68, 0
  s_cselect_b32 s67, s67, s68
  s_branch L_havetag
L_kswitch:
  s_mov_b32 s62, 0
  s_add_u32 s45, s66, s71
  s_mov_b64 s[96:97], s[8:9]
  s_mov_b64 s[28:29], s[8:9]
  s_lshl_b32 s46, s45, 12
  s_add_u32 s54, s46, 4096
  s_lshl_b32 s48, s45, 4
  buffer_load_short_d16_hi v16, v5, s[24:27], s48 offen nt
  buffer_load_short_d16_hi v17, v5, s[20:23], s48 offen nt
  s_branch L_kgo
L_vctl:
  s_cmp_eq_u32 s49, 14
  s_cbranch_scc1 L_vlast
  s_cmp_eq_u32 s49, 11
  s_cbranch_scc1 L_flagld
  s_cmp_eq_u32 s49, 12
  s_cbranch_scc1 L_flagchk
  s_cmp_lg_u32 s49, 0
  s_cbranch_scc1 L_vctl_done
  s_mov_b32 s61, 0
  s_cmp_eq_u32 s68, 0
  s_cbranch_scc1 L_vctl_done
  s_mov_b32 s68, 1
  s_atomic_or s68, s[36:37], s70 glc
  s_branch L_vctl_done
L_flagld:
  s_mov_b64 exec, 1
  buffer_load_dword v190, v191, s[36:39], s70 offen sc1
  s_mov_b64 exec, -1
  s_branch L_vctl_done
L_flagchk:
  s_waitcnt vmcnt(10)
  v_readfirstlane_b32 s51, v190
  s_nop 3
  s_andn2_b32 s67, s51, 1
  s_and_b32 s51, s51, 1
  s_or_b32 s59, s59, s51
  s_branch L_vctl_done
L_vlast:
  s_cmp_eq_u32 s61, 0
  s_cbranch_scc1 L_tpV
  s_waitcnt lgkmcnt(0)
  s_add_u32 s51, s58, 1
  v_mov_b32 v190, s51
  ds_write_b32 v197, v190
  s_branch L_tgV
L_tpV:
  ds_read_b32 v190, v197
  s_waitcnt lgkmcnt(0)
  v_readfirstlane_b32 s51, v190
  s_nop 3
  s_cmp_eq_u32 s51, 0
  s_cbranch_scc1 L_tpV
  s_sub_u32 s58, s51, 1
L_tgV:
  v_add_u32 v197, 8, v197
  s_and_b32 s45, s58, 1
  s_lshl_b32 s45, s45, 3
  s_and_b32 s53, s58, 6
  s_lshl_b32 s53, s53, 7
  s_add_u32 s45, s45, s53
  s_and_b32 s53, s58, 8
  s_lshr_b32 s53, s53, 1
  s_add_u32 s45, s45, s53
  s_add_u32 s45, s45, s3
  s_add_u32 s45, s45, s56
  s_lshr_b32 s51, s58, 4
  s_mov_b32 s53, 240
  s_xor_b32 s53, s53, s71
  s_add_u32 s45, s45, s53
  s_cmp_lt_u32 s58, 16
  s_cselect_b32 s45, s45, 32768
  s_mov_b64 s[96:97], s[4:5]
  v_and_b32 v5, 15, v5
  s_lshl_b32 s46, s45, 12
  s_add_u32 s54, s46, 0
  s_lshr_b32 s47, s45, 3
  s_lshl_b32 s47, s47, 8
  s_lshl_b32 s48, s45, 4
  buffer_load_dwordx2 v[12:13], v4, s[16:19], s47 offen nt
  buffer_load_dwordx2 v[14:15], v4, s[12:15], s47 offen nt
  s_branch L_vgo
.section .rodata,"a"
.p2align 6
.amdhsa_kernel standalone__kv_cache_quant_int4_int2_kv_with_per_channel_or_per_token_scales__decode_kernel
  .amdhsa_next_free_vgpr 208
  .amdhsa_next_free_sgpr 102
  .amdhsa_accum_offset 208
  .amdhsa_group_segment_fixed_size 0
  .amdhsa_kernarg_size 80
  .amdhsa_user_sgpr_count 2
  .amdhsa_user_sgpr_kernarg_segment_ptr 1
  .amdhsa_system_sgpr_workgroup_id_x 1
  .amdhsa_float_denorm_mode_32 3
  .amdhsa_float_denorm_mode_16_64 3
.end_amdhsa_kernel
```
